```python
import torch

def _softmax(x, axis=-1):
    return torch.softmax(x, dim=axis)
def _gelu(x):
    return torch.nn.functional.gelu(x, approximate="tanh")
def _silu(x):
    return torch.nn.functional.silu(x)
def _sigmoid(x):
    return torch.sigmoid(x)
def _layernorm(x, axis=-1, eps=1e-5):
    m = x.mean(dim=axis, keepdim=True)
    v = x.var(dim=axis, keepdim=True, unbiased=False)
    return (x - m) / torch.sqrt(v + eps)
def _scatter_add(tgt, idx, src, axis=0):
    return tgt.clone().index_add_(axis, idx, src)
def _segment_sum(src, seg, n):
    out = torch.zeros((n,) + src.shape[1:], dtype=src.dtype)
    return out.index_add_(0, seg, src)
def _pad(x, pw):
    flat = tuple(v for pair in reversed(pw) for v in pair)
    return torch.nn.functional.pad(x, flat)

kernel_name = 'standalone__weight_only_int_gptq__prompt'

def setup_inputs():

    _w = (lambda a: (lambda t: t.to(torch.bfloat16) if t.is_floating_point() else t)(torch.as_tensor(a)))
    B, S, D, F = 1, 2048, 576, 4608
    bits = max(2, min(4, 4))
    pf = 32 // bits
    G = -1 if -1 > 0 else D
    G = max(pf, (G // pf) * pf)
    D = max(G, (D // G) * G)
    ng = D // G
    qmax = 1 << bits
    qw = torch.randint(0, qmax, (D, F)).to(torch.int64)
    packed = torch.zeros((D // pf, F), dtype=torch.int64)
    for i in range(pf):
        packed |= (qw[i::pf] << (i * bits))
    packed = packed.to(torch.int32)
    return {
        "x": _w((lambda *s: torch.randn(*s, dtype=torch.bfloat16) * 0.05)(B, S, D)),
        "qw_packed": _w(packed),
        "scales": _w(torch.abs((lambda *s: torch.randn(*s, dtype=torch.bfloat16) * 0.05)(ng, F)).to(float) * 0.1 + 0.01),
        "zeros": _w(torch.randint(0, qmax, (ng, F)).to(float)),
        "bits": _w((lambda _x: torch.as_tensor(_x, dtype=torch.int32))(bits)),
    }

def reference(x, qw_packed, scales, zeros, bits):
    b = int(bits)
    pf = 32 // b
    mask = (1 << b) - 1
    P, F = qw_packed.shape
    D = P * pf
    ng = scales.shape[0]
    G = D // ng
    shifts = (lambda x, dt: x.to(dt))(torch.arange(pf) * b, qw_packed.dtype)
    qw = ((qw_packed[:, None, :] >> shifts[None, :, None]) & mask).reshape(D, F)
    s = (lambda x, n, axis: torch.repeat_interleave(x, n, dim=axis))(scales, G, axis=0)
    z = (lambda x, n, axis: torch.repeat_interleave(x, n, dim=axis))(zeros, G, axis=0)
    w = ((lambda x, dt: x.to(dt))(qw, x.dtype) - z) * s
    return torch.einsum("bsd,df->bsf", x, w)
```

```asm
; @launch grid=(256,1,1) block=(512,1,1) lds=159232
.amdgcn_target "amdgcn-amd-amdhsa--gfx950"
.text
.globl standalone__weight_only_int_gptq__prompt_kernel
.p2align 8
.type standalone__weight_only_int_gptq__prompt_kernel,@function
standalone__weight_only_int_gptq__prompt_kernel:
    s_cmp_ge_u32 s2, 256
    s_cbranch_scc1 L_done
    s_load_dwordx2 s[20:21], s[0:1], 0
    s_load_dwordx2 s[24:25], s[0:1], 8
    s_load_dwordx2 s[28:29], s[0:1], 16
    s_load_dwordx2 s[32:33], s[0:1], 24
    s_load_dwordx2 s[36:37], s[0:1], 40
    v_lshrrev_b32 v1, 6, v0
    v_and_b32 v0, 63, v0
    s_and_b32 s14, s2, 7
    v_readfirstlane_b32 s3, v1
    s_lshr_b32 s15, s2, 3
    s_and_b32 s16, s14, 3
    s_lshr_b32 s17, s14, 2
    s_mul_i32 s16, s16, 4
    s_mul_i32 s17, s17, 8
    s_and_b32 s18, s15, 3
    s_lshr_b32 s19, s15, 2
    s_add_u32 s16, s16, s18
    s_add_u32 s17, s17, s19
    s_mov_b32 s22, 2359296
    s_mov_b32 s23, 0x00020000
    s_mov_b32 s26, 1327104
    s_mov_b32 s27, 0x00020000
    v_and_b32 v2, 15, v0
    v_lshrrev_b32 v3, 4, v0
    v_bfe_u32 v1, v0, 2, 3
    v_mul_u32_u24 v4, 1152, v1
    v_lshrrev_b32 v1, 5, v0
    v_lshl_add_u32 v4, v1, 6, v4
    v_bfe_i32 v1, v0, 4, 1
    v_xor_b32 v1, v1, v0
    v_and_b32 v1, 3, v1
    v_lshl_add_u32 v4, v1, 4, v4
    v_xor_b32 v5, 32, v4
    v_mul_u32_u24 v6, 18432, v3
    v_lshl_add_u32 v6, v2, 3, v6
    s_mul_i32 s18, s16, 147456
    s_mul_i32 s58, s3, 18432
    s_add_u32 s18, s18, s58
    s_mul_i32 s19, s17, 1152
    s_lshl_b32 s58, s3, 7
    s_add_u32 s15, s19, s58
    s_mul_i32 s66, s3, 18432
    s_add_u32 s13, s16, s17
    s_mul_i32 s58, s13, 43
    s_lshr_b32 s58, s58, 7
    s_mul_i32 s58, s58, 3
    s_sub_u32 s13, s13, s58
    s_mov_b32 s60, s13
    s_mul_i32 s4, s60, 384
    s_add_u32 s4, s4, s18
    s_mul_i32 s7, s60, 442368
    s_add_u32 s7, s7, s15
    s_waitcnt lgkmcnt(0)
    s_add_u32 s59, s7, 0
    buffer_load_dwordx2 v[118:119], v6, s[24:27], s59 offen
    s_add_u32 s59, s7, 73728
    buffer_load_dwordx2 v[126:127], v6, s[24:27], s59 offen
    s_add_u32 m0, s66, 0
    s_add_u32 s58, s4, 0
    buffer_load_dwordx4 v4, s[20:23], s58 offen lds
    s_add_u32 m0, s66, 9216
    s_add_u32 s58, s4, 9216
    buffer_load_dwordx4 v5, s[20:23], s58 offen lds
    s_mov_b32 s38, 18874368
    s_mov_b32 s39, 0x00020000
    v_mul_u32_u24 v7, 9216, v2
    v_lshl_add_u32 v7, v3, 4, v7
    v_lshrrev_b32 v1, 3, v2
    v_mul_u32_u24 v12, 9216, v1
    v_and_b32 v1, 7, v2
    v_lshl_add_u32 v12, v1, 6, v12
    v_lshrrev_b32 v1, 2, v2
    v_sub_u32 v1, 0, v1
    v_xor_b32 v1, v1, v3
    v_and_b32 v1, 3, v1
    v_lshl_add_u32 v12, v1, 4, v12
    v_mov_b32 v13, v12
    v_mov_b32 v14, v12
    v_lshlrev_b32 v15, 2, v2
    v_add_u32 v15, 147456, v15
    v_mov_b32 v16, v15
    v_mov_b32 v17, v15
    s_getpc_b64 s[58:59]
    v_lshlrev_b32 v56, 7, v0
    s_lshl_b32 s61, s3, 10
    v_cmp_gt_u32 vcc, 9, v0
    s_mul_i32 s61, s3, 1152
    v_add_u32 v56, s61, v56
    v_mov_b32 v57, s59
    s_mov_b64 exec, vcc
    v_add_co_u32 v56, vcc, s58, v56
    s_nop 1
    v_addc_co_u32 v57, vcc, 0, v57, vcc
    global_load_dword v56, v[56:57], off
    s_mov_b64 exec, -1
    s_barrier
    s_add_u32 m0, s66, 1024
    s_add_u32 s58, s4, 128
    buffer_load_dwordx4 v4, s[20:23], s58 offen lds
    s_add_u32 m0, s66, 10240
    s_add_u32 s58, s4, 9344
    buffer_load_dwordx4 v5, s[20:23], s58 offen lds
    s_add_u32 s59, s7, 147456
    buffer_load_dwordx2 v[134:135], v6, s[24:27], s59 offen
    s_add_u32 s59, s7, 221184
    buffer_load_dwordx2 v[142:143], v6, s[24:27], s59 offen
    s_mov_b32 s60, s13
    s_add_u32 s60, s60, 1
    s_cmp_eq_u32 s60, 3
    s_cselect_b32 s60, 0, s60
    s_mul_i32 s5, s60, 384
    s_add_u32 s5, s5, s18
    s_mul_i32 s8, s60, 442368
    s_add_u32 s8, s8, s15
    s_add_u32 s60, s60, 1
    s_cmp_eq_u32 s60, 3
    s_cselect_b32 s60, 0, s60
    s_mul_i32 s6, s60, 384
    s_add_u32 s6, s6, s18
    s_mul_i32 s9, s60, 442368
    s_add_u32 s9, s9, s15
    s_mov_b32 s30, 9216
    s_mov_b32 s31, 0x00020000
    s_mov_b32 s34, 9216
    s_mov_b32 s35, 0x00020000
    s_mul_i32 s67, s17, 576
    s_mov_b32 s64, 0x000f000f
    s_mul_i32 s65, s16, 1179648
    s_add_u32 s65, s65, s67
    s_and_b32 s14, s3, 3
    s_mul_i32 s50, s14, 294912
    s_add_u32 s50, s50, s65
    s_add_u32 s50, s50, 512
    s_add_u32 s51, s50, 147456
    s_lshl_b32 s58, s3, 6
    s_add_u32 s65, s65, s58
    v_mov_b32 v8, 0x43004300
    v_mov_b32 v9, 0x00040000
    v_mov_b32 v10, 0x000c0008
    v_mov_b32 v11, 0x43000000
    v_lshrrev_b32 v1, 3, v0
    v_mul_u32_u24 v18, 18432, v1
    v_and_b32 v1, 7, v0
    v_lshl_add_u32 v18, v1, 4, v18
    v_lshlrev_b32 v19, 4, v0
    s_mov_b32 s42, 0
    s_lshr_b32 s55, s3, 2
    s_add_u32 s10, s3, 0
    s_and_b32 s10, s10, 7
    s_mul_i32 s60, s10, 18432
    v_add_u32 v13, s60, v12
    s_mul_i32 s52, s10, 147456
    s_add_u32 s52, s52, s65
    s_add_u32 s11, s3, 1
    s_and_b32 s11, s11, 7
    s_mul_i32 s60, s11, 18432
    v_add_u32 v14, s60, v12
    s_mul_i32 s53, s11, 147456
    s_add_u32 s53, s53, s65
    s_add_u32 s12, s3, 2
    s_and_b32 s12, s12, 7
    s_mul_i32 s60, s12, 18432
    v_add_u32 v16, s60, v12
    s_mul_i32 s54, s12, 147456
    s_add_u32 s54, s54, s65
    s_add_u32 s49, s3, 3
    s_and_b32 s49, s49, 7
    s_mul_i32 s60, s49, 18432
    v_add_u32 v17, s60, v12
    s_mul_i32 s44, s49, 147456
    s_add_u32 s44, s44, s65
    v_mov_b32 v60, 0x3f803f80
    v_mov_b32 v61, 0x3f803f80
    v_mov_b32 v62, 0x3f803f80
    v_mov_b32 v63, 0x3f803f80
    s_waitcnt vmcnt(7)
    v_pk_lshrrev_b16 v112, v9, v118 op_sel:[0,0] op_sel_hi:[1,0]
    v_pk_lshrrev_b16 v113, v10, v118 op_sel:[0,0] op_sel_hi:[1,0]
    v_pk_lshrrev_b16 v114, v9, v118 op_sel:[0,1] op_sel_hi:[1,1]
    v_pk_lshrrev_b16 v115, v10, v118 op_sel:[0,1] op_sel_hi:[1,1]
    v_and_or_b32 v112, v112, s64, v8
    v_and_or_b32 v113, v113, s64, v8
    v_and_or_b32 v114, v114, s64, v8
    v_and_or_b32 v115, v115, s64, v8
    v_pk_lshrrev_b16 v116, v9, v119 op_sel:[0,0] op_sel_hi:[1,0]
    v_pk_lshrrev_b16 v117, v10, v119 op_sel:[0,0] op_sel_hi:[1,0]
    v_pk_lshrrev_b16 v118, v9, v119 op_sel:[0,1] op_sel_hi:[1,1]
    v_pk_lshrrev_b16 v119, v10, v119 op_sel:[0,1] op_sel_hi:[1,1]
    v_and_or_b32 v116, v116, s64, v8
    v_and_or_b32 v117, v117, s64, v8
    v_and_or_b32 v118, v118, s64, v8
    v_and_or_b32 v119, v119, s64, v8
    v_pk_lshrrev_b16 v120, v9, v126 op_sel:[0,0] op_sel_hi:[1,0]
    v_pk_lshrrev_b16 v121, v10, v126 op_sel:[0,0] op_sel_hi:[1,0]
    v_pk_lshrrev_b16 v122, v9, v126 op_sel:[0,1] op_sel_hi:[1,1]
    v_pk_lshrrev_b16 v123, v10, v126 op_sel:[0,1] op_sel_hi:[1,1]
    v_and_or_b32 v120, v120, s64, v8
    v_and_or_b32 v121, v121, s64, v8
    v_and_or_b32 v122, v122, s64, v8
    v_and_or_b32 v123, v123, s64, v8
    s_waitcnt vmcnt(5)
    s_barrier
    ds_read_b128 v[68:71], v13 offset:0
    ds_read_b128 v[72:75], v14 offset:0
    ds_read_b128 v[76:79], v16 offset:0
    ds_read_b128 v[80:83], v17 offset:0
    s_waitcnt lgkmcnt(2)
    v_mfma_f32_16x16x32_bf16 v[84:87], v[112:115], v[68:71], 0
    ds_read_b128 v[20:23], v13 offset:512
    v_pk_lshrrev_b16 v124, v9, v127 op_sel:[0,0] op_sel_hi:[1,0]
    v_pk_lshrrev_b16 v125, v10, v127 op_sel:[0,0] op_sel_hi:[1,0]
    v_mfma_f32_16x16x32_bf16 v[88:91], v[116:119], v[68:71], 0
    s_add_u32 m0, s66, 2048
    s_add_u32 s58, s4, 256
    buffer_load_dwordx4 v4, s[20:23], s58 offen lds
    v_pk_lshrrev_b16 v126, v9, v127 op_sel:[0,1] op_sel_hi:[1,1]
    v_mfma_f32_16x16x32_bf16 v[64:67], v[60:63], v[68:71], 0
    s_add_u32 s59, s7, 294912
    buffer_load_dwordx2 v[150:151], v6, s[24:27], s59 offen
    v_pk_lshrrev_b16 v127, v10, v127 op_sel:[0,1] op_sel_hi:[1,1]
    v_and_or_b32 v124, v124, s64, v8
    v_mfma_f32_16x16x32_bf16 v[92:95], v[112:115], v[72:75], 0
    ds_read_b128 v[24:27], v14 offset:512
    v_and_or_b32 v125, v125, s64, v8
    v_and_or_b32 v126, v126, s64, v8
    v_mfma_f32_16x16x32_bf16 v[96:99], v[116:119], v[72:75], 0
    s_add_u32 m0, s66, 11264
    s_add_u32 s58, s4, 9472
    buffer_load_dwordx4 v5, s[20:23], s58 offen lds
    v_and_or_b32 v127, v127, s64, v8
    s_waitcnt lgkmcnt(2)
    v_mfma_f32_16x16x32_bf16 v[100:103], v[112:115], v[76:79], 0
    ds_read_b128 v[68:71], v16 offset:512
    s_waitcnt vmcnt(4)
    v_pk_lshrrev_b16 v128, v9, v134 op_sel:[0,0] op_sel_hi:[1,0]
    v_pk_lshrrev_b16 v129, v10, v134 op_sel:[0,0] op_sel_hi:[1,0]
    v_mfma_f32_16x16x32_bf16 v[104:107], v[116:119], v[76:79], 0
    s_add_u32 s59, s7, 368640
    buffer_load_dwordx2 v[158:159], v6, s[24:27], s59 offen
    v_pk_lshrrev_b16 v130, v9, v134 op_sel:[0,1] op_sel_hi:[1,1]
    v_pk_lshrrev_b16 v131, v10, v134 op_sel:[0,1] op_sel_hi:[1,1]
    v_mfma_f32_16x16x32_bf16 v[28:31], v[112:115], v[80:83], 0
    ds_read_b128 v[72:75], v17 offset:512
    v_and_or_b32 v128, v128, s64, v8
    v_mfma_f32_16x16x32_bf16 v[32:35], v[116:119], v[80:83], 0
    v_and_or_b32 v129, v129, s64, v8
    v_and_or_b32 v130, v130, s64, v8
    v_and_or_b32 v131, v131, s64, v8
    s_waitcnt vmcnt(6)
    s_barrier
    s_waitcnt lgkmcnt(2)
    v_mfma_f32_16x16x32_bf16 v[84:87], v[120:123], v[20:23], v[84:87]
    ds_read_b128 v[76:79], v13 offset:1024
    v_pk_lshrrev_b16 v132, v9, v135 op_sel:[0,0] op_sel_hi:[1,0]
    v_pk_lshrrev_b16 v133, v10, v135 op_sel:[0,0] op_sel_hi:[1,0]
    v_mfma_f32_16x16x32_bf16 v[88:91], v[124:127], v[20:23], v[88:91]
    s_add_u32 m0, s66, 3072
    s_add_u32 s58, s5, 0
    buffer_load_dwordx4 v4, s[20:23], s58 offen lds
    v_pk_lshrrev_b16 v134, v9, v135 op_sel:[0,1] op_sel_hi:[1,1]
    v_mfma_f32_16x16x32_bf16 v[64:67], v[60:63], v[20:23], v[64:67]
    s_add_u32 s59, s8, 0
    buffer_load_dwordx2 v[166:167], v6, s[24:27], s59 offen
    v_pk_lshrrev_b16 v135, v10, v135 op_sel:[0,1] op_sel_hi:[1,1]
    v_and_or_b32 v132, v132, s64, v8
    v_mfma_f32_16x16x32_bf16 v[92:95], v[120:123], v[24:27], v[92:95]
    ds_read_b128 v[80:83], v14 offset:1024
    v_and_or_b32 v133, v133, s64, v8
    v_and_or_b32 v134, v134, s64, v8
    v_mfma_f32_16x16x32_bf16 v[96:99], v[124:127], v[24:27], v[96:99]
    s_add_u32 m0, s66, 12288
    s_add_u32 s58, s5, 9216
    buffer_load_dwordx4 v5, s[20:23], s58 offen lds
    v_and_or_b32 v135, v135, s64, v8
    s_waitcnt lgkmcnt(2)
    v_mfma_f32_16x16x32_bf16 v[100:103], v[120:123], v[68:71], v[100:103]
    ds_read_b128 v[20:23], v16 offset:1024
    s_waitcnt vmcnt(7)
    v_pk_lshrrev_b16 v136, v9, v142 op_sel:[0,0] op_sel_hi:[1,0]
    v_pk_lshrrev_b16 v137, v10, v142 op_sel:[0,0] op_sel_hi:[1,0]
    v_mfma_f32_16x16x32_bf16 v[104:107], v[124:127], v[68:71], v[104:107]
    s_add_u32 s59, s8, 73728
    buffer_load_dwordx2 v[174:175], v6, s[24:27], s59 offen
    v_pk_lshrrev_b16 v138, v9, v142 op_sel:[0,1] op_sel_hi:[1,1]
    v_pk_lshrrev_b16 v139, v10, v142 op_sel:[0,1] op_sel_hi:[1,1]
    v_mfma_f32_16x16x32_bf16 v[28:31], v[120:123], v[72:75], v[28:31]
    ds_read_b128 v[24:27], v17 offset:1024
    v_and_or_b32 v136, v136, s64, v8
    v_mfma_f32_16x16x32_bf16 v[32:35], v[124:127], v[72:75], v[32:35]
    v_and_or_b32 v137, v137, s64, v8
    v_and_or_b32 v138, v138, s64, v8
    v_and_or_b32 v139, v139, s64, v8
    s_waitcnt lgkmcnt(2)
    v_mfma_f32_16x16x32_bf16 v[84:87], v[128:131], v[76:79], v[84:87]
    ds_read_b128 v[68:71], v13 offset:1536
    v_pk_lshrrev_b16 v140, v9, v143 op_sel:[0,0] op_sel_hi:[1,0]
    v_mfma_f32_16x16x32_bf16 v[88:91], v[132:135], v[76:79], v[88:91]
    v_pk_lshrrev_b16 v141, v10, v143 op_sel:[0,0] op_sel_hi:[1,0]
    v_pk_lshrrev_b16 v142, v9, v143 op_sel:[0,1] op_sel_hi:[1,1]
    v_pk_lshrrev_b16 v143, v10, v143 op_sel:[0,1] op_sel_hi:[1,1]
    v_mfma_f32_16x16x32_bf16 v[64:67], v[60:63], v[76:79], v[64:67]
    s_add_u32 m0, s66, 4096
    s_add_u32 s58, s5, 128
    buffer_load_dwordx4 v4, s[20:23], s58 offen lds
    v_and_or_b32 v140, v140, s64, v8
    v_mfma_f32_16x16x32_bf16 v[92:95], v[128:131], v[80:83], v[92:95]
    ds_read_b128 v[72:75], v14 offset:1536
    v_and_or_b32 v141, v141, s64, v8
    v_and_or_b32 v142, v142, s64, v8
    v_mfma_f32_16x16x32_bf16 v[96:99], v[132:135], v[80:83], v[96:99]
    v_and_or_b32 v143, v143, s64, v8
    s_waitcnt vmcnt(7)
    v_pk_lshrrev_b16 v144, v9, v150 op_sel:[0,0] op_sel_hi:[1,0]
    s_waitcnt lgkmcnt(2)
    v_mfma_f32_16x16x32_bf16 v[100:103], v[128:131], v[20:23], v[100:103]
    ds_read_b128 v[76:79], v16 offset:1536
    v_pk_lshrrev_b16 v145, v10, v150 op_sel:[0,0] op_sel_hi:[1,0]
    v_pk_lshrrev_b16 v146, v9, v150 op_sel:[0,1] op_sel_hi:[1,1]
    v_mfma_f32_16x16x32_bf16 v[104:107], v[132:135], v[20:23], v[104:107]
    s_add_u32 s59, s8, 147456
    buffer_load_dwordx2 v[182:183], v6, s[24:27], s59 offen
    v_pk_lshrrev_b16 v147, v10, v150 op_sel:[0,1] op_sel_hi:[1,1]
    v_mfma_f32_16x16x32_bf16 v[28:31], v[128:131], v[24:27], v[28:31]
    ds_read_b128 v[80:83], v17 offset:1536
    v_and_or_b32 v144, v144, s64, v8
    v_and_or_b32 v145, v145, s64, v8
    v_mfma_f32_16x16x32_bf16 v[32:35], v[132:135], v[24:27], v[32:35]
    v_and_or_b32 v146, v146, s64, v8
    v_and_or_b32 v147, v147, s64, v8
    s_waitcnt vmcnt(7)
    s_barrier
    s_waitcnt lgkmcnt(2)
    v_mfma_f32_16x16x32_bf16 v[84:87], v[136:139], v[68:71], v[84:87]
    ds_read_b128 v[20:23], v13 offset:2048
    v_pk_lshrrev_b16 v148, v9, v151 op_sel:[0,0] op_sel_hi:[1,0]
    v_mfma_f32_16x16x32_bf16 v[88:91], v[140:143], v[68:71], v[88:91]
    v_pk_lshrrev_b16 v149, v10, v151 op_sel:[0,0] op_sel_hi:[1,0]
    v_pk_lshrrev_b16 v150, v9, v151 op_sel:[0,1] op_sel_hi:[1,1]
    v_pk_lshrrev_b16 v151, v10, v151 op_sel:[0,1] op_sel_hi:[1,1]
    v_mfma_f32_16x16x32_bf16 v[64:67], v[60:63], v[68:71], v[64:67]
    s_add_u32 m0, s66, 13312
    s_add_u32 s58, s5, 9344
    buffer_load_dwordx4 v5, s[20:23], s58 offen lds
    v_and_or_b32 v148, v148, s64, v8
    v_mfma_f32_16x16x32_bf16 v[92:95], v[136:139], v[72:75], v[92:95]
    ds_read_b128 v[24:27], v14 offset:2048
    v_and_or_b32 v149, v149, s64, v8
    v_and_or_b32 v150, v150, s64, v8
    v_mfma_f32_16x16x32_bf16 v[96:99], v[140:143], v[72:75], v[96:99]
    v_and_or_b32 v151, v151, s64, v8
    s_waitcnt vmcnt(7)
    v_pk_lshrrev_b16 v152, v9, v158 op_sel:[0,0] op_sel_hi:[1,0]
    s_waitcnt lgkmcnt(2)
    v_mfma_f32_16x16x32_bf16 v[100:103], v[136:139], v[76:79], v[100:103]
    ds_read_b128 v[68:71], v16 offset:2048
    v_pk_lshrrev_b16 v153, v10, v158 op_sel:[0,0] op_sel_hi:[1,0]
    v_pk_lshrrev_b16 v154, v9, v158 op_sel:[0,1] op_sel_hi:[1,1]
    v_mfma_f32_16x16x32_bf16 v[104:107], v[140:143], v[76:79], v[104:107]
    s_add_u32 s59, s8, 221184
    buffer_load_dwordx2 v[190:191], v6, s[24:27], s59 offen
    v_pk_lshrrev_b16 v155, v10, v158 op_sel:[0,1] op_sel_hi:[1,1]
    v_mfma_f32_16x16x32_bf16 v[28:31], v[136:139], v[80:83], v[28:31]
    ds_read_b128 v[72:75], v17 offset:2048
    v_and_or_b32 v152, v152, s64, v8
    v_and_or_b32 v153, v153, s64, v8
    v_mfma_f32_16x16x32_bf16 v[32:35], v[140:143], v[80:83], v[32:35]
    v_and_or_b32 v154, v154, s64, v8
    v_and_or_b32 v155, v155, s64, v8
    s_waitcnt lgkmcnt(2)
    v_mfma_f32_16x16x32_bf16 v[84:87], v[144:147], v[20:23], v[84:87]
    ds_read_b128 v[76:79], v13 offset:2560
    v_pk_lshrrev_b16 v156, v9, v159 op_sel:[0,0] op_sel_hi:[1,0]
    v_mfma_f32_16x16x32_bf16 v[88:91], v[148:151], v[20:23], v[88:91]
    v_pk_lshrrev_b16 v157, v10, v159 op_sel:[0,0] op_sel_hi:[1,0]
    v_pk_lshrrev_b16 v158, v9, v159 op_sel:[0,1] op_sel_hi:[1,1]
    v_pk_lshrrev_b16 v159, v10, v159 op_sel:[0,1] op_sel_hi:[1,1]
    v_mfma_f32_16x16x32_bf16 v[64:67], v[60:63], v[20:23], v[64:67]
    s_add_u32 m0, s66, 5120
    s_add_u32 s58, s5, 256
    buffer_load_dwordx4 v4, s[20:23], s58 offen lds
    v_and_or_b32 v156, v156, s64, v8
    v_mfma_f32_16x16x32_bf16 v[92:95], v[144:147], v[24:27], v[92:95]
    ds_read_b128 v[80:83], v14 offset:2560
    v_and_or_b32 v157, v157, s64, v8
    v_and_or_b32 v158, v158, s64, v8
    v_mfma_f32_16x16x32_bf16 v[96:99], v[148:151], v[24:27], v[96:99]
    v_and_or_b32 v159, v159, s64, v8
    s_waitcnt vmcnt(7)
    v_pk_lshrrev_b16 v160, v9, v166 op_sel:[0,0] op_sel_hi:[1,0]
    s_waitcnt lgkmcnt(2)
    v_mfma_f32_16x16x32_bf16 v[100:103], v[144:147], v[68:71], v[100:103]
    ds_read_b128 v[20:23], v16 offset:2560
    v_pk_lshrrev_b16 v161, v10, v166 op_sel:[0,0] op_sel_hi:[1,0]
    v_pk_lshrrev_b16 v162, v9, v166 op_sel:[0,1] op_sel_hi:[1,1]
    v_mfma_f32_16x16x32_bf16 v[104:107], v[148:151], v[68:71], v[104:107]
    s_add_u32 s59, s8, 294912
    buffer_load_dwordx2 v[198:199], v6, s[24:27], s59 offen
    v_pk_lshrrev_b16 v163, v10, v166 op_sel:[0,1] op_sel_hi:[1,1]
    v_mfma_f32_16x16x32_bf16 v[28:31], v[144:147], v[72:75], v[28:31]
    ds_read_b128 v[24:27], v17 offset:2560
    v_and_or_b32 v160, v160, s64, v8
    v_and_or_b32 v161, v161, s64, v8
    v_mfma_f32_16x16x32_bf16 v[32:35], v[148:151], v[72:75], v[32:35]
    v_and_or_b32 v162, v162, s64, v8
    v_and_or_b32 v163, v163, s64, v8
    s_waitcnt vmcnt(7)
    s_barrier
    s_waitcnt lgkmcnt(2)
    v_mfma_f32_16x16x32_bf16 v[84:87], v[152:155], v[76:79], v[84:87]
    ds_read_b128 v[68:71], v13 offset:3072
    v_pk_lshrrev_b16 v164, v9, v167 op_sel:[0,0] op_sel_hi:[1,0]
    v_mfma_f32_16x16x32_bf16 v[88:91], v[156:159], v[76:79], v[88:91]
    v_pk_lshrrev_b16 v165, v10, v167 op_sel:[0,0] op_sel_hi:[1,0]
    v_pk_lshrrev_b16 v166, v9, v167 op_sel:[0,1] op_sel_hi:[1,1]
    v_pk_lshrrev_b16 v167, v10, v167 op_sel:[0,1] op_sel_hi:[1,1]
    v_mfma_f32_16x16x32_bf16 v[64:67], v[60:63], v[76:79], v[64:67]
    s_add_u32 m0, s66, 14336
    s_add_u32 s58, s5, 9472
    buffer_load_dwordx4 v5, s[20:23], s58 offen lds
    v_and_or_b32 v164, v164, s64, v8
    v_mfma_f32_16x16x32_bf16 v[92:95], v[152:155], v[80:83], v[92:95]
    ds_read_b128 v[72:75], v14 offset:3072
    v_and_or_b32 v165, v165, s64, v8
    v_and_or_b32 v166, v166, s64, v8
    v_mfma_f32_16x16x32_bf16 v[96:99], v[156:159], v[80:83], v[96:99]
    v_and_or_b32 v167, v167, s64, v8
    s_waitcnt vmcnt(7)
    v_pk_lshrrev_b16 v168, v9, v174 op_sel:[0,0] op_sel_hi:[1,0]
    s_waitcnt lgkmcnt(2)
    v_mfma_f32_16x16x32_bf16 v[100:103], v[152:155], v[20:23], v[100:103]
    ds_read_b128 v[76:79], v16 offset:3072
    v_pk_lshrrev_b16 v169, v10, v174 op_sel:[0,0] op_sel_hi:[1,0]
    v_pk_lshrrev_b16 v170, v9, v174 op_sel:[0,1] op_sel_hi:[1,1]
    v_mfma_f32_16x16x32_bf16 v[104:107], v[156:159], v[20:23], v[104:107]
    s_add_u32 s59, s8, 368640
    buffer_load_dwordx2 v[206:207], v6, s[24:27], s59 offen
    v_pk_lshrrev_b16 v171, v10, v174 op_sel:[0,1] op_sel_hi:[1,1]
    v_mfma_f32_16x16x32_bf16 v[28:31], v[152:155], v[24:27], v[28:31]
    ds_read_b128 v[80:83], v17 offset:3072
    v_and_or_b32 v168, v168, s64, v8
    v_and_or_b32 v169, v169, s64, v8
    v_mfma_f32_16x16x32_bf16 v[32:35], v[156:159], v[24:27], v[32:35]
    v_and_or_b32 v170, v170, s64, v8
    v_and_or_b32 v171, v171, s64, v8
    s_waitcnt lgkmcnt(2)
    v_mfma_f32_16x16x32_bf16 v[84:87], v[160:163], v[68:71], v[84:87]
    ds_read_b128 v[20:23], v13 offset:3584
    v_pk_lshrrev_b16 v172, v9, v175 op_sel:[0,0] op_sel_hi:[1,0]
    v_mfma_f32_16x16x32_bf16 v[88:91], v[164:167], v[68:71], v[88:91]
    v_pk_lshrrev_b16 v173, v10, v175 op_sel:[0,0] op_sel_hi:[1,0]
    v_pk_lshrrev_b16 v174, v9, v175 op_sel:[0,1] op_sel_hi:[1,1]
    v_pk_lshrrev_b16 v175, v10, v175 op_sel:[0,1] op_sel_hi:[1,1]
    v_mfma_f32_16x16x32_bf16 v[64:67], v[60:63], v[68:71], v[64:67]
    s_add_u32 m0, s66, 6144
    s_add_u32 s58, s6, 0
    buffer_load_dwordx4 v4, s[20:23], s58 offen lds
    v_and_or_b32 v172, v172, s64, v8
    v_mfma_f32_16x16x32_bf16 v[92:95], v[160:163], v[72:75], v[92:95]
    ds_read_b128 v[24:27], v14 offset:3584
    v_and_or_b32 v173, v173, s64, v8
    v_and_or_b32 v174, v174, s64, v8
    v_mfma_f32_16x16x32_bf16 v[96:99], v[164:167], v[72:75], v[96:99]
    v_and_or_b32 v175, v175, s64, v8
    s_waitcnt vmcnt(7)
    v_pk_lshrrev_b16 v176, v9, v182 op_sel:[0,0] op_sel_hi:[1,0]
    s_waitcnt lgkmcnt(2)
    v_mfma_f32_16x16x32_bf16 v[100:103], v[160:163], v[76:79], v[100:103]
    ds_read_b128 v[68:71], v16 offset:3584
    v_pk_lshrrev_b16 v177, v10, v182 op_sel:[0,0] op_sel_hi:[1,0]
    v_pk_lshrrev_b16 v178, v9, v182 op_sel:[0,1] op_sel_hi:[1,1]
    v_mfma_f32_16x16x32_bf16 v[104:107], v[164:167], v[76:79], v[104:107]
    s_add_u32 s59, s9, 0
    buffer_load_dwordx2 v[214:215], v6, s[24:27], s59 offen
    v_pk_lshrrev_b16 v179, v10, v182 op_sel:[0,1] op_sel_hi:[1,1]
    v_mfma_f32_16x16x32_bf16 v[28:31], v[160:163], v[80:83], v[28:31]
    ds_read_b128 v[72:75], v17 offset:3584
    v_and_or_b32 v176, v176, s64, v8
    v_and_or_b32 v177, v177, s64, v8
    v_mfma_f32_16x16x32_bf16 v[32:35], v[164:167], v[80:83], v[32:35]
    v_and_or_b32 v178, v178, s64, v8
    v_and_or_b32 v179, v179, s64, v8
    s_waitcnt vmcnt(7)
    s_barrier
    s_waitcnt lgkmcnt(2)
    v_mfma_f32_16x16x32_bf16 v[84:87], v[168:171], v[20:23], v[84:87]
    ds_read_b128 v[76:79], v13 offset:4096
    v_pk_lshrrev_b16 v180, v9, v183 op_sel:[0,0] op_sel_hi:[1,0]
    v_mfma_f32_16x16x32_bf16 v[88:91], v[172:175], v[20:23], v[88:91]
    v_pk_lshrrev_b16 v181, v10, v183 op_sel:[0,0] op_sel_hi:[1,0]
    v_pk_lshrrev_b16 v182, v9, v183 op_sel:[0,1] op_sel_hi:[1,1]
    v_pk_lshrrev_b16 v183, v10, v183 op_sel:[0,1] op_sel_hi:[1,1]
    v_mfma_f32_16x16x32_bf16 v[64:67], v[60:63], v[20:23], v[64:67]
    s_add_u32 m0, s66, 15360
    s_add_u32 s58, s6, 9216
    buffer_load_dwordx4 v5, s[20:23], s58 offen lds
    v_and_or_b32 v180, v180, s64, v8
    v_mfma_f32_16x16x32_bf16 v[92:95], v[168:171], v[24:27], v[92:95]
    ds_read_b128 v[80:83], v14 offset:4096
    v_and_or_b32 v181, v181, s64, v8
    v_and_or_b32 v182, v182, s64, v8
    v_mfma_f32_16x16x32_bf16 v[96:99], v[172:175], v[24:27], v[96:99]
    v_and_or_b32 v183, v183, s64, v8
    s_waitcnt vmcnt(7)
    v_pk_lshrrev_b16 v184, v9, v190 op_sel:[0,0] op_sel_hi:[1,0]
    s_waitcnt lgkmcnt(2)
    v_mfma_f32_16x16x32_bf16 v[100:103], v[168:171], v[68:71], v[100:103]
    ds_read_b128 v[20:23], v16 offset:4096
    v_pk_lshrrev_b16 v185, v10, v190 op_sel:[0,0] op_sel_hi:[1,0]
    v_pk_lshrrev_b16 v186, v9, v190 op_sel:[0,1] op_sel_hi:[1,1]
    v_mfma_f32_16x16x32_bf16 v[104:107], v[172:175], v[68:71], v[104:107]
    s_add_u32 s59, s9, 73728
    buffer_load_dwordx2 v[222:223], v6, s[24:27], s59 offen
    v_pk_lshrrev_b16 v187, v10, v190 op_sel:[0,1] op_sel_hi:[1,1]
    v_mfma_f32_16x16x32_bf16 v[28:31], v[168:171], v[72:75], v[28:31]
    ds_read_b128 v[24:27], v17 offset:4096
    v_and_or_b32 v184, v184, s64, v8
    v_and_or_b32 v185, v185, s64, v8
    v_mfma_f32_16x16x32_bf16 v[32:35], v[172:175], v[72:75], v[32:35]
    v_and_or_b32 v186, v186, s64, v8
    v_and_or_b32 v187, v187, s64, v8
    s_waitcnt lgkmcnt(2)
    v_mfma_f32_16x16x32_bf16 v[84:87], v[176:179], v[76:79], v[84:87]
    ds_read_b128 v[68:71], v13 offset:4608
    v_pk_lshrrev_b16 v188, v9, v191 op_sel:[0,0] op_sel_hi:[1,0]
    v_mfma_f32_16x16x32_bf16 v[88:91], v[180:183], v[76:79], v[88:91]
    v_pk_lshrrev_b16 v189, v10, v191 op_sel:[0,0] op_sel_hi:[1,0]
    v_pk_lshrrev_b16 v190, v9, v191 op_sel:[0,1] op_sel_hi:[1,1]
    v_pk_lshrrev_b16 v191, v10, v191 op_sel:[0,1] op_sel_hi:[1,1]
    v_mfma_f32_16x16x32_bf16 v[64:67], v[60:63], v[76:79], v[64:67]
    s_add_u32 m0, s66, 7168
    s_add_u32 s58, s6, 128
    buffer_load_dwordx4 v4, s[20:23], s58 offen lds
    v_and_or_b32 v188, v188, s64, v8
    v_mfma_f32_16x16x32_bf16 v[92:95], v[176:179], v[80:83], v[92:95]
    ds_read_b128 v[72:75], v14 offset:4608
    v_and_or_b32 v189, v189, s64, v8
    v_and_or_b32 v190, v190, s64, v8
    v_mfma_f32_16x16x32_bf16 v[96:99], v[180:183], v[80:83], v[96:99]
    v_and_or_b32 v191, v191, s64, v8
    s_waitcnt vmcnt(7)
    v_pk_lshrrev_b16 v192, v9, v198 op_sel:[0,0] op_sel_hi:[1,0]
    s_waitcnt lgkmcnt(2)
    v_mfma_f32_16x16x32_bf16 v[100:103], v[176:179], v[20:23], v[100:103]
    ds_read_b128 v[76:79], v16 offset:4608
    v_pk_lshrrev_b16 v193, v10, v198 op_sel:[0,0] op_sel_hi:[1,0]
    v_pk_lshrrev_b16 v194, v9, v198 op_sel:[0,1] op_sel_hi:[1,1]
    v_mfma_f32_16x16x32_bf16 v[104:107], v[180:183], v[20:23], v[104:107]
    s_add_u32 s59, s9, 147456
    buffer_load_dwordx2 v[230:231], v6, s[24:27], s59 offen
    v_pk_lshrrev_b16 v195, v10, v198 op_sel:[0,1] op_sel_hi:[1,1]
    v_mfma_f32_16x16x32_bf16 v[28:31], v[176:179], v[24:27], v[28:31]
    ds_read_b128 v[80:83], v17 offset:4608
    v_and_or_b32 v192, v192, s64, v8
    v_and_or_b32 v193, v193, s64, v8
    v_mfma_f32_16x16x32_bf16 v[32:35], v[180:183], v[24:27], v[32:35]
    v_and_or_b32 v194, v194, s64, v8
    v_and_or_b32 v195, v195, s64, v8
    s_waitcnt vmcnt(7)
    s_barrier
    s_waitcnt lgkmcnt(2)
    v_mfma_f32_16x16x32_bf16 v[84:87], v[184:187], v[68:71], v[84:87]
    ds_read_b128 v[20:23], v13 offset:5120
    v_pk_lshrrev_b16 v196, v9, v199 op_sel:[0,0] op_sel_hi:[1,0]
    v_mfma_f32_16x16x32_bf16 v[88:91], v[188:191], v[68:71], v[88:91]
    v_pk_lshrrev_b16 v197, v10, v199 op_sel:[0,0] op_sel_hi:[1,0]
    v_pk_lshrrev_b16 v198, v9, v199 op_sel:[0,1] op_sel_hi:[1,1]
    v_pk_lshrrev_b16 v199, v10, v199 op_sel:[0,1] op_sel_hi:[1,1]
    v_mfma_f32_16x16x32_bf16 v[64:67], v[60:63], v[68:71], v[64:67]
    s_add_u32 m0, s66, 16384
    s_add_u32 s58, s6, 9344
    buffer_load_dwordx4 v5, s[20:23], s58 offen lds
    v_and_or_b32 v196, v196, s64, v8
    v_mfma_f32_16x16x32_bf16 v[92:95], v[184:187], v[72:75], v[92:95]
    ds_read_b128 v[24:27], v14 offset:5120
    v_and_or_b32 v197, v197, s64, v8
    v_and_or_b32 v198, v198, s64, v8
    v_mfma_f32_16x16x32_bf16 v[96:99], v[188:191], v[72:75], v[96:99]
    v_and_or_b32 v199, v199, s64, v8
    s_waitcnt vmcnt(7)
    v_pk_lshrrev_b16 v200, v9, v206 op_sel:[0,0] op_sel_hi:[1,0]
    s_waitcnt lgkmcnt(2)
    v_mfma_f32_16x16x32_bf16 v[100:103], v[184:187], v[76:79], v[100:103]
    ds_read_b128 v[68:71], v16 offset:5120
    v_pk_lshrrev_b16 v201, v10, v206 op_sel:[0,0] op_sel_hi:[1,0]
    v_pk_lshrrev_b16 v202, v9, v206 op_sel:[0,1] op_sel_hi:[1,1]
    v_mfma_f32_16x16x32_bf16 v[104:107], v[188:191], v[76:79], v[104:107]
    s_add_u32 s59, s9, 221184
    buffer_load_dwordx2 v[238:239], v6, s[24:27], s59 offen
    v_pk_lshrrev_b16 v203, v10, v206 op_sel:[0,1] op_sel_hi:[1,1]
    v_mfma_f32_16x16x32_bf16 v[28:31], v[184:187], v[80:83], v[28:31]
    ds_read_b128 v[72:75], v17 offset:5120
    v_and_or_b32 v200, v200, s64, v8
    v_and_or_b32 v201, v201, s64, v8
    v_mfma_f32_16x16x32_bf16 v[32:35], v[188:191], v[80:83], v[32:35]
    v_and_or_b32 v202, v202, s64, v8
    v_and_or_b32 v203, v203, s64, v8
    s_waitcnt lgkmcnt(2)
    v_mfma_f32_16x16x32_bf16 v[84:87], v[192:195], v[20:23], v[84:87]
    ds_read_b128 v[76:79], v13 offset:5632
    v_pk_lshrrev_b16 v204, v9, v207 op_sel:[0,0] op_sel_hi:[1,0]
    v_mfma_f32_16x16x32_bf16 v[88:91], v[196:199], v[20:23], v[88:91]
    v_pk_lshrrev_b16 v205, v10, v207 op_sel:[0,0] op_sel_hi:[1,0]
    v_pk_lshrrev_b16 v206, v9, v207 op_sel:[0,1] op_sel_hi:[1,1]
    v_pk_lshrrev_b16 v207, v10, v207 op_sel:[0,1] op_sel_hi:[1,1]
    v_mfma_f32_16x16x32_bf16 v[64:67], v[60:63], v[20:23], v[64:67]
    s_add_u32 m0, s66, 8192
    s_add_u32 s58, s6, 256
    buffer_load_dwordx4 v4, s[20:23], s58 offen lds
    v_and_or_b32 v204, v204, s64, v8
    v_mfma_f32_16x16x32_bf16 v[92:95], v[192:195], v[24:27], v[92:95]
    ds_read_b128 v[80:83], v14 offset:5632
    v_and_or_b32 v205, v205, s64, v8
    v_and_or_b32 v206, v206, s64, v8
    v_mfma_f32_16x16x32_bf16 v[96:99], v[196:199], v[24:27], v[96:99]
    v_and_or_b32 v207, v207, s64, v8
    s_waitcnt vmcnt(7)
    v_pk_lshrrev_b16 v208, v9, v214 op_sel:[0,0] op_sel_hi:[1,0]
    s_waitcnt lgkmcnt(2)
    v_mfma_f32_16x16x32_bf16 v[100:103], v[192:195], v[68:71], v[100:103]
    ds_read_b128 v[20:23], v16 offset:5632
    v_pk_lshrrev_b16 v209, v10, v214 op_sel:[0,0] op_sel_hi:[1,0]
    v_pk_lshrrev_b16 v210, v9, v214 op_sel:[0,1] op_sel_hi:[1,1]
    v_mfma_f32_16x16x32_bf16 v[104:107], v[196:199], v[68:71], v[104:107]
    s_add_u32 s59, s9, 294912
    buffer_load_dwordx2 v[246:247], v6, s[24:27], s59 offen
    v_pk_lshrrev_b16 v211, v10, v214 op_sel:[0,1] op_sel_hi:[1,1]
    v_mfma_f32_16x16x32_bf16 v[28:31], v[192:195], v[72:75], v[28:31]
    ds_read_b128 v[24:27], v17 offset:5632
    v_and_or_b32 v208, v208, s64, v8
    v_and_or_b32 v209, v209, s64, v8
    v_mfma_f32_16x16x32_bf16 v[32:35], v[196:199], v[72:75], v[32:35]
    v_and_or_b32 v210, v210, s64, v8
    v_and_or_b32 v211, v211, s64, v8
    s_waitcnt vmcnt(7)
    s_barrier
    s_waitcnt lgkmcnt(2)
    v_mfma_f32_16x16x32_bf16 v[84:87], v[200:203], v[76:79], v[84:87]
    ds_read_b128 v[68:71], v13 offset:6144
    v_pk_lshrrev_b16 v212, v9, v215 op_sel:[0,0] op_sel_hi:[1,0]
    v_mfma_f32_16x16x32_bf16 v[88:91], v[204:207], v[76:79], v[88:91]
    v_pk_lshrrev_b16 v213, v10, v215 op_sel:[0,0] op_sel_hi:[1,0]
    v_pk_lshrrev_b16 v214, v9, v215 op_sel:[0,1] op_sel_hi:[1,1]
    v_pk_lshrrev_b16 v215, v10, v215 op_sel:[0,1] op_sel_hi:[1,1]
    v_mfma_f32_16x16x32_bf16 v[64:67], v[60:63], v[76:79], v[64:67]
    s_add_u32 m0, s66, 17408
    s_add_u32 s58, s6, 9472
    buffer_load_dwordx4 v5, s[20:23], s58 offen lds
    v_and_or_b32 v212, v212, s64, v8
    v_mfma_f32_16x16x32_bf16 v[92:95], v[200:203], v[80:83], v[92:95]
    ds_read_b128 v[72:75], v14 offset:6144
    v_and_or_b32 v213, v213, s64, v8
    v_and_or_b32 v214, v214, s64, v8
    v_mfma_f32_16x16x32_bf16 v[96:99], v[204:207], v[80:83], v[96:99]
    v_and_or_b32 v215, v215, s64, v8
    s_waitcnt vmcnt(7)
    v_pk_lshrrev_b16 v216, v9, v222 op_sel:[0,0] op_sel_hi:[1,0]
    s_waitcnt lgkmcnt(2)
    v_mfma_f32_16x16x32_bf16 v[100:103], v[200:203], v[20:23], v[100:103]
    ds_read_b128 v[76:79], v16 offset:6144
    v_pk_lshrrev_b16 v217, v10, v222 op_sel:[0,0] op_sel_hi:[1,0]
    v_pk_lshrrev_b16 v218, v9, v222 op_sel:[0,1] op_sel_hi:[1,1]
    v_mfma_f32_16x16x32_bf16 v[104:107], v[204:207], v[20:23], v[104:107]
    s_add_u32 s59, s9, 368640
    buffer_load_dwordx2 v[254:255], v6, s[24:27], s59 offen
    v_pk_lshrrev_b16 v219, v10, v222 op_sel:[0,1] op_sel_hi:[1,1]
    v_mfma_f32_16x16x32_bf16 v[28:31], v[200:203], v[24:27], v[28:31]
    ds_read_b128 v[80:83], v17 offset:6144
    v_and_or_b32 v216, v216, s64, v8
    v_and_or_b32 v217, v217, s64, v8
    v_mfma_f32_16x16x32_bf16 v[32:35], v[204:207], v[24:27], v[32:35]
    v_and_or_b32 v218, v218, s64, v8
    v_and_or_b32 v219, v219, s64, v8
    s_cmp_gt_u32 s3, 2
    s_cbranch_scc1 L_x3
    s_cmp_eq_u32 s3, 1
    s_cbranch_scc1 L_x1
    s_cmp_eq_u32 s3, 2
    s_cbranch_scc1 L_x2
    s_mov_b32 m0, 156160
    s_add_u32 s58, s9, 295936
    buffer_load_dwordx4 v18, s[24:27], s58 offen lds
    s_branch L_x3
L_x1:
    s_mov_b32 m0, 157184
    s_nop 0
    buffer_load_dwordx4 v19, s[28:31], s67 offen lds
    s_branch L_x3
L_x2:
    s_mov_b32 m0, 158208
    s_nop 0
    buffer_load_dwordx4 v19, s[32:35], s67 offen lds
L_x3:
    s_waitcnt lgkmcnt(2)
    v_mfma_f32_16x16x32_bf16 v[84:87], v[208:211], v[68:71], v[84:87]
    ds_read_b128 v[20:23], v13 offset:6656
    v_pk_lshrrev_b16 v220, v9, v223 op_sel:[0,0] op_sel_hi:[1,0]
    v_mfma_f32_16x16x32_bf16 v[88:91], v[212:215], v[68:71], v[88:91]
    v_pk_lshrrev_b16 v221, v10, v223 op_sel:[0,0] op_sel_hi:[1,0]
    v_pk_lshrrev_b16 v222, v9, v223 op_sel:[0,1] op_sel_hi:[1,1]
    v_pk_lshrrev_b16 v223, v10, v223 op_sel:[0,1] op_sel_hi:[1,1]
    v_mfma_f32_16x16x32_bf16 v[64:67], v[60:63], v[68:71], v[64:67]
    s_lshl_b32 s58, s3, 10
    s_add_u32 m0, s58, 147968
    s_mul_i32 s58, s13, 3
    s_add_u32 s58, s58, s3
    s_cmp_ge_u32 s58, 9
    s_cselect_b32 s59, 9, 0
    s_sub_u32 s58, s58, s59
    s_mul_i32 s58, s58, 147456
    s_add_u32 s58, s58, s19
    s_add_u32 s58, s58, 1024
    buffer_load_dwordx4 v18, s[24:27], s58 offen lds
    v_and_or_b32 v220, v220, s64, v8
    v_mfma_f32_16x16x32_bf16 v[92:95], v[208:211], v[72:75], v[92:95]
    ds_read_b128 v[24:27], v14 offset:6656
    v_and_or_b32 v221, v221, s64, v8
    v_mfma_f32_16x16x32_bf16 v[96:99], v[212:215], v[72:75], v[96:99]
    v_and_or_b32 v222, v222, s64, v8
    v_and_or_b32 v223, v223, s64, v8
    s_waitcnt vmcnt(7)
    v_pk_lshrrev_b16 v224, v9, v230 op_sel:[0,0] op_sel_hi:[1,0]
    s_waitcnt lgkmcnt(2)
    v_mfma_f32_16x16x32_bf16 v[100:103], v[208:211], v[76:79], v[100:103]
    ds_read_b128 v[68:71], v16 offset:6656
    v_pk_lshrrev_b16 v225, v10, v230 op_sel:[0,0] op_sel_hi:[1,0]
    v_mfma_f32_16x16x32_bf16 v[104:107], v[212:215], v[76:79], v[104:107]
    v_pk_lshrrev_b16 v226, v9, v230 op_sel:[0,1] op_sel_hi:[1,1]
    v_pk_lshrrev_b16 v227, v10, v230 op_sel:[0,1] op_sel_hi:[1,1]
    v_mfma_f32_16x16x32_bf16 v[28:31], v[208:211], v[80:83], v[28:31]
    ds_read_b128 v[72:75], v17 offset:6656
    v_and_or_b32 v224, v224, s64, v8
    v_and_or_b32 v225, v225, s64, v8
    v_mfma_f32_16x16x32_bf16 v[32:35], v[212:215], v[80:83], v[32:35]
    v_and_or_b32 v226, v226, s64, v8
    v_and_or_b32 v227, v227, s64, v8
    s_waitcnt vmcnt(6)
    s_barrier
    s_waitcnt lgkmcnt(2)
    v_mfma_f32_16x16x32_bf16 v[84:87], v[216:219], v[20:23], v[84:87]
    ds_read_b128 v[76:79], v13 offset:7168
    v_pk_lshrrev_b16 v228, v9, v231 op_sel:[0,0] op_sel_hi:[1,0]
    v_mfma_f32_16x16x32_bf16 v[88:91], v[220:223], v[20:23], v[88:91]
    v_pk_lshrrev_b16 v229, v10, v231 op_sel:[0,0] op_sel_hi:[1,0]
    v_pk_lshrrev_b16 v230, v9, v231 op_sel:[0,1] op_sel_hi:[1,1]
    v_mfma_f32_16x16x32_bf16 v[64:67], v[60:63], v[20:23], v[64:67]
    v_pk_lshrrev_b16 v231, v10, v231 op_sel:[0,1] op_sel_hi:[1,1]
    v_and_or_b32 v228, v228, s64, v8
    v_and_or_b32 v229, v229, s64, v8
    v_mfma_f32_16x16x32_bf16 v[92:95], v[216:219], v[24:27], v[92:95]
    ds_read_b128 v[80:83], v14 offset:7168
    v_and_or_b32 v230, v230, s64, v8
    v_mfma_f32_16x16x32_bf16 v[96:99], v[220:223], v[24:27], v[96:99]
    v_and_or_b32 v231, v231, s64, v8
    s_waitcnt vmcnt(5)
    v_pk_lshrrev_b16 v232, v9, v238 op_sel:[0,0] op_sel_hi:[1,0]
    s_waitcnt lgkmcnt(2)
    v_mfma_f32_16x16x32_bf16 v[100:103], v[216:219], v[68:71], v[100:103]
    ds_read_b128 v[20:23], v16 offset:7168
    v_pk_lshrrev_b16 v233, v10, v238 op_sel:[0,0] op_sel_hi:[1,0]
    v_mfma_f32_16x16x32_bf16 v[104:107], v[220:223], v[68:71], v[104:107]
    v_pk_lshrrev_b16 v234, v9, v238 op_sel:[0,1] op_sel_hi:[1,1]
    v_pk_lshrrev_b16 v235, v10, v238 op_sel:[0,1] op_sel_hi:[1,1]
    v_and_or_b32 v232, v232, s64, v8
    v_mfma_f32_16x16x32_bf16 v[28:31], v[216:219], v[72:75], v[28:31]
    ds_read_b128 v[24:27], v17 offset:7168
    v_and_or_b32 v233, v233, s64, v8
    v_mfma_f32_16x16x32_bf16 v[32:35], v[220:223], v[72:75], v[32:35]
    v_and_or_b32 v234, v234, s64, v8
    v_and_or_b32 v235, v235, s64, v8
    s_waitcnt lgkmcnt(2)
    v_mfma_f32_16x16x32_bf16 v[84:87], v[224:227], v[76:79], v[84:87]
    ds_read_b128 v[68:71], v13 offset:7680
    v_pk_lshrrev_b16 v236, v9, v239 op_sel:[0,0] op_sel_hi:[1,0]
    v_mfma_f32_16x16x32_bf16 v[88:91], v[228:231], v[76:79], v[88:91]
    v_pk_lshrrev_b16 v237, v10, v239 op_sel:[0,0] op_sel_hi:[1,0]
    v_pk_lshrrev_b16 v238, v9, v239 op_sel:[0,1] op_sel_hi:[1,1]
    v_mfma_f32_16x16x32_bf16 v[64:67], v[60:63], v[76:79], v[64:67]
    v_pk_lshrrev_b16 v239, v10, v239 op_sel:[0,1] op_sel_hi:[1,1]
    v_and_or_b32 v236, v236, s64, v8
    v_and_or_b32 v237, v237, s64, v8
    v_mfma_f32_16x16x32_bf16 v[92:95], v[224:227], v[80:83], v[92:95]
    ds_read_b128 v[72:75], v14 offset:7680
    v_and_or_b32 v238, v238, s64, v8
    v_mfma_f32_16x16x32_bf16 v[96:99], v[228:231], v[80:83], v[96:99]
    v_and_or_b32 v239, v239, s64, v8
    s_waitcnt vmcnt(3)
    v_pk_lshrrev_b16 v240, v9, v246 op_sel:[0,0] op_sel_hi:[1,0]
    s_waitcnt lgkmcnt(2)
    v_mfma_f32_16x16x32_bf16 v[100:103], v[224:227], v[20:23], v[100:103]
    ds_read_b128 v[76:79], v16 offset:7680
    v_pk_lshrrev_b16 v241, v10, v246 op_sel:[0,0] op_sel_hi:[1,0]
    v_mfma_f32_16x16x32_bf16 v[104:107], v[228:231], v[20:23], v[104:107]
    v_pk_lshrrev_b16 v242, v9, v246 op_sel:[0,1] op_sel_hi:[1,1]
    v_pk_lshrrev_b16 v243, v10, v246 op_sel:[0,1] op_sel_hi:[1,1]
    v_and_or_b32 v240, v240, s64, v8
    v_mfma_f32_16x16x32_bf16 v[28:31], v[224:227], v[24:27], v[28:31]
    ds_read_b128 v[80:83], v17 offset:7680
    v_and_or_b32 v241, v241, s64, v8
    v_mfma_f32_16x16x32_bf16 v[32:35], v[228:231], v[24:27], v[32:35]
    v_and_or_b32 v242, v242, s64, v8
    v_and_or_b32 v243, v243, s64, v8
    s_waitcnt vmcnt(0)
    s_barrier
    s_waitcnt lgkmcnt(2)
    v_mfma_f32_16x16x32_bf16 v[84:87], v[232:235], v[68:71], v[84:87]
    ds_read_b128 v[20:23], v13 offset:8192
    v_pk_lshrrev_b16 v244, v9, v247 op_sel:[0,0] op_sel_hi:[1,0]
    v_pk_lshrrev_b16 v245, v10, v247 op_sel:[0,0] op_sel_hi:[1,0]
    v_mfma_f32_16x16x32_bf16 v[88:91], v[236:239], v[68:71], v[88:91]
    v_pk_lshrrev_b16 v246, v9, v247 op_sel:[0,1] op_sel_hi:[1,1]
    v_pk_lshrrev_b16 v247, v10, v247 op_sel:[0,1] op_sel_hi:[1,1]
    v_mfma_f32_16x16x32_bf16 v[64:67], v[60:63], v[68:71], v[64:67]
    ds_read_b128 v[52:55], v13 offset:8704
    v_and_or_b32 v244, v244, s64, v8
    v_and_or_b32 v245, v245, s64, v8
    v_mfma_f32_16x16x32_bf16 v[92:95], v[232:235], v[72:75], v[92:95]
    ds_read_b128 v[24:27], v14 offset:8192
    v_and_or_b32 v246, v246, s64, v8
    v_and_or_b32 v247, v247, s64, v8
    v_mfma_f32_16x16x32_bf16 v[96:99], v[236:239], v[72:75], v[96:99]
    s_lshl_b32 s58, s3, 6
    s_add_u32 s58, s58, 157184
    v_lshlrev_b32 v19, 4, v3
    v_add_u32 v19, s58, v19
    s_waitcnt vmcnt(1)
    v_pk_lshrrev_b16 v248, v9, v254 op_sel:[0,0] op_sel_hi:[1,0]
    s_waitcnt lgkmcnt(3)
    v_mfma_f32_16x16x32_bf16 v[100:103], v[232:235], v[76:79], v[100:103]
    ds_read_b128 v[68:71], v16 offset:8192
    v_pk_lshrrev_b16 v249, v10, v254 op_sel:[0,0] op_sel_hi:[1,0]
    v_pk_lshrrev_b16 v250, v9, v254 op_sel:[0,1] op_sel_hi:[1,1]
    v_mfma_f32_16x16x32_bf16 v[104:107], v[236:239], v[76:79], v[104:107]
    ds_read_b128 v[40:43], v19
    v_pk_lshrrev_b16 v251, v10, v254 op_sel:[0,1] op_sel_hi:[1,1]
    v_and_or_b32 v248, v248, s64, v8
    v_mfma_f32_16x16x32_bf16 v[28:31], v[232:235], v[80:83], v[28:31]
    ds_read_b128 v[72:75], v17 offset:8192
    v_and_or_b32 v249, v249, s64, v8
    v_mfma_f32_16x16x32_bf16 v[32:35], v[236:239], v[80:83], v[32:35]
    ds_read_b128 v[48:51], v19 offset:1024
    v_and_or_b32 v250, v250, s64, v8
    v_and_or_b32 v251, v251, s64, v8
    s_waitcnt lgkmcnt(4)
    v_mfma_f32_16x16x32_bf16 v[84:87], v[240:243], v[20:23], v[84:87]
    ds_read_b128 v[76:79], v13 offset:8704
    v_pk_lshrrev_b16 v252, v9, v255 op_sel:[0,0] op_sel_hi:[1,0]
    v_mfma_f32_16x16x32_bf16 v[88:91], v[244:247], v[20:23], v[88:91]
    v_pk_lshrrev_b16 v253, v10, v255 op_sel:[0,0] op_sel_hi:[1,0]
    v_pk_lshrrev_b16 v254, v9, v255 op_sel:[0,1] op_sel_hi:[1,1]
    v_pk_lshrrev_b16 v255, v10, v255 op_sel:[0,1] op_sel_hi:[1,1]
    v_mfma_f32_16x16x32_bf16 v[64:67], v[60:63], v[20:23], v[64:67]
    v_and_or_b32 v252, v252, s64, v8
    v_and_or_b32 v253, v253, s64, v8
    v_mfma_f32_16x16x32_bf16 v[64:67], v[60:63], v[52:55], v[64:67]
    v_and_or_b32 v254, v254, s64, v8
    v_and_or_b32 v255, v255, s64, v8
    s_waitcnt lgkmcnt(1)
    v_lshlrev_b32 v36, 16, v40
    v_mfma_f32_16x16x32_bf16 v[92:95], v[240:243], v[24:27], v[92:95]
    ds_read_b128 v[80:83], v14 offset:8704
    v_and_b32 v40, 0xffff0000, v40
    v_mfma_f32_16x16x32_bf16 v[96:99], v[244:247], v[24:27], v[96:99]
    s_lshl_b32 s58, s3, 6
    v_add_u32 v18, s58, v15
    v_lshlrev_b32 v44, 16, v48
    v_mfma_f32_16x16x32_bf16 v[100:103], v[240:243], v[68:71], v[100:103]
    ds_read_b128 v[20:23], v16 offset:8704
    v_and_b32 v48, 0xffff0000, v48
    v_lshlrev_b32 v37, 16, v41
    v_mfma_f32_16x16x32_bf16 v[104:107], v[244:247], v[68:71], v[104:107]
    ds_write_b32 v18, v64
    v_and_b32 v41, 0xffff0000, v41
    v_mfma_f32_16x16x32_bf16 v[28:31], v[240:243], v[72:75], v[28:31]
    ds_read_b128 v[24:27], v17 offset:8704
    v_lshlrev_b32 v45, 16, v49
    v_and_b32 v49, 0xffff0000, v49
    v_mfma_f32_16x16x32_bf16 v[32:35], v[244:247], v[72:75], v[32:35]
    v_lshlrev_b32 v38, 16, v42
    v_and_b32 v42, 0xffff0000, v42
    s_waitcnt lgkmcnt(1)
    s_barrier
    v_mfma_f32_16x16x32_bf16 v[84:87], v[248:251], v[76:79], v[84:87]
    s_lshl_b32 s58, s11, 6
    v_add_u32 v18, s58, v15
    ds_read_b32 v65, v18
    v_lshlrev_b32 v46, 16, v50
    v_mfma_f32_16x16x32_bf16 v[88:91], v[252:255], v[76:79], v[88:91]
    v_and_b32 v50, 0xffff0000, v50
    v_lshlrev_b32 v39, 16, v43
    v_mfma_f32_16x16x32_bf16 v[92:95], v[248:251], v[80:83], v[92:95]
    s_lshl_b32 s58, s12, 6
    v_add_u32 v18, s58, v15
    ds_read_b32 v66, v18
    v_and_b32 v43, 0xffff0000, v43
    v_mfma_f32_16x16x32_bf16 v[96:99], v[252:255], v[80:83], v[96:99]
    v_lshlrev_b32 v47, 16, v51
    v_and_b32 v51, 0xffff0000, v51
    v_add_f32 v44, v11, v44
    s_waitcnt lgkmcnt(2)
    v_mfma_f32_16x16x32_bf16 v[100:103], v[248:251], v[20:23], v[100:103]
    s_lshl_b32 s58, s49, 6
    v_add_u32 v18, s58, v15
    ds_read_b32 v56, v18
    v_add_f32 v45, v11, v45
    v_mfma_f32_16x16x32_bf16 v[104:107], v[252:255], v[20:23], v[104:107]
    v_add_f32 v46, v11, v46
    v_add_f32 v47, v11, v47
    v_mfma_f32_16x16x32_bf16 v[28:31], v[248:251], v[24:27], v[28:31]
    v_add_f32 v48, v11, v48
    v_add_f32 v49, v11, v49
    v_mfma_f32_16x16x32_bf16 v[32:35], v[252:255], v[24:27], v[32:35]
    v_add_f32 v50, v11, v50
    v_add_f32 v51, v11, v51
    s_add_u32 s43, s49, 1
    s_and_b32 s43, s43, 7
    s_mul_i32 s60, s43, 18432
    v_add_u32 v13, s60, v12
    s_mul_i32 s45, s43, 147456
    s_add_u32 s45, s45, s65
    s_cmp_ge_u32 s3, 4
    s_cbranch_scc1 L_pa
    s_setprio 1
L_pa:
    s_mov_b64 exec, 0
    s_nop 4
    s_cmp_eq_u32 s3, 4
    s_cbranch_scc1 L_seg0
    s_cmp_eq_u32 s3, 5
    s_cbranch_scc1 L_seg1
    s_cmp_eq_u32 s3, 6
    s_cbranch_scc1 L_seg2
    s_cmp_eq_u32 s3, 7
    s_cbranch_scc1 L_seg3
L_wret:
    s_nop 7
    s_mov_b64 exec, -1
    ds_read_b128 v[68:71], v13 offset:0
    ds_read_b128 v[72:75], v13 offset:512
    ds_read_b128 v[76:79], v13 offset:1024
    v_fma_f32 v84, -v44, v64, v84
    v_fma_f32 v85, -v45, v64, v85
    v_fma_f32 v86, -v46, v64, v86
    v_fma_f32 v87, -v47, v64, v87
    v_fma_f32 v88, -v48, v64, v88
    v_fma_f32 v89, -v49, v64, v89
    v_fma_f32 v90, -v50, v64, v90
    v_fma_f32 v91, -v51, v64, v91
    v_mul_f32 v84, v36, v84
    v_mul_f32 v85, v37, v85
    v_mul_f32 v86, v38, v86
    v_mul_f32 v87, v39, v87
    v_mul_f32 v88, v40, v88
    v_mul_f32 v89, v41, v89
    v_mul_f32 v90, v42, v90
    v_mul_f32 v91, v43, v91
    v_cvt_pk_bf16_f32 v52, v84, v88
    v_cvt_pk_bf16_f32 v53, v85, v89
    v_cvt_pk_bf16_f32 v54, v86, v90
    v_cvt_pk_bf16_f32 v55, v87, v91
    buffer_store_dwordx4 v[52:55], v7, s[36:39], s52 offen sc1
    s_branch L_trip
L_pref:
    ds_read_b128 v[68:71], v13 offset:0
    ds_read_b128 v[72:75], v13 offset:512
    ds_read_b128 v[76:79], v13 offset:1024
L_trip:
    s_waitcnt lgkmcnt(2)
    v_mfma_f32_16x16x32_bf16 v[20:23], v[112:115], v[68:71], 0
    ds_read_b128 v[80:83], v13 offset:1536
    v_mfma_f32_16x16x32_bf16 v[24:27], v[116:119], v[68:71], 0
    s_add_u32 s61, s43, 1
    s_waitcnt lgkmcnt(2)
    v_mfma_f32_16x16x32_bf16 v[20:23], v[120:123], v[72:75], v[20:23]
    ds_read_b128 v[68:71], v13 offset:2048
    v_mfma_f32_16x16x32_bf16 v[24:27], v[124:127], v[72:75], v[24:27]
    s_and_b32 s61, s61, 7
    s_waitcnt lgkmcnt(2)
    v_mfma_f32_16x16x32_bf16 v[20:23], v[128:131], v[76:79], v[20:23]
    ds_read_b128 v[72:75], v13 offset:2560
    v_fma_f32 v28, -v44, v56, v28
    v_mfma_f32_16x16x32_bf16 v[24:27], v[132:135], v[76:79], v[24:27]
    v_fma_f32 v29, -v45, v56, v29
    s_waitcnt lgkmcnt(2)
    v_mfma_f32_16x16x32_bf16 v[20:23], v[136:139], v[80:83], v[20:23]
    ds_read_b128 v[76:79], v13 offset:3072
    v_fma_f32 v30, -v46, v56, v30
    v_mfma_f32_16x16x32_bf16 v[24:27], v[140:143], v[80:83], v[24:27]
    v_fma_f32 v31, -v47, v56, v31
    s_waitcnt lgkmcnt(2)
    v_mfma_f32_16x16x32_bf16 v[20:23], v[144:147], v[68:71], v[20:23]
    ds_read_b128 v[80:83], v13 offset:3584
    v_fma_f32 v32, -v48, v56, v32
    v_mfma_f32_16x16x32_bf16 v[24:27], v[148:151], v[68:71], v[24:27]
    v_fma_f32 v33, -v49, v56, v33
    s_waitcnt lgkmcnt(2)
    v_mfma_f32_16x16x32_bf16 v[20:23], v[152:155], v[72:75], v[20:23]
    ds_read_b128 v[68:71], v13 offset:4096
    v_fma_f32 v34, -v50, v56, v34
    v_mfma_f32_16x16x32_bf16 v[24:27], v[156:159], v[72:75], v[24:27]
    v_fma_f32 v35, -v51, v56, v35
    s_waitcnt lgkmcnt(2)
    v_mfma_f32_16x16x32_bf16 v[20:23], v[160:163], v[76:79], v[20:23]
    ds_read_b128 v[72:75], v13 offset:4608
    v_mul_f32 v28, v36, v28
    v_mfma_f32_16x16x32_bf16 v[24:27], v[164:167], v[76:79], v[24:27]
    v_mul_f32 v29, v37, v29
    s_waitcnt lgkmcnt(2)
    v_mfma_f32_16x16x32_bf16 v[20:23], v[168:171], v[80:83], v[20:23]
    ds_read_b128 v[76:79], v13 offset:5120
    v_mul_f32 v30, v38, v30
    v_mfma_f32_16x16x32_bf16 v[24:27], v[172:175], v[80:83], v[24:27]
    v_mul_f32 v31, v39, v31
    s_waitcnt lgkmcnt(2)
    v_mfma_f32_16x16x32_bf16 v[20:23], v[176:179], v[68:71], v[20:23]
    ds_read_b128 v[80:83], v13 offset:5632
    v_mul_f32 v32, v40, v32
    v_mfma_f32_16x16x32_bf16 v[24:27], v[180:183], v[68:71], v[24:27]
    v_mul_f32 v33, v41, v33
    s_waitcnt lgkmcnt(2)
    v_mfma_f32_16x16x32_bf16 v[20:23], v[184:187], v[72:75], v[20:23]
    ds_read_b128 v[68:71], v13 offset:6144
    v_mul_f32 v34, v42, v34
    v_mfma_f32_16x16x32_bf16 v[24:27], v[188:191], v[72:75], v[24:27]
    v_mul_f32 v35, v43, v35
    s_waitcnt lgkmcnt(2)
    v_mfma_f32_16x16x32_bf16 v[20:23], v[192:195], v[76:79], v[20:23]
    ds_read_b128 v[72:75], v13 offset:6656
    v_cvt_pk_bf16_f32 v52, v28, v32
    v_mfma_f32_16x16x32_bf16 v[24:27], v[196:199], v[76:79], v[24:27]
    v_cvt_pk_bf16_f32 v53, v29, v33
    s_waitcnt lgkmcnt(2)
    v_mfma_f32_16x16x32_bf16 v[20:23], v[200:203], v[80:83], v[20:23]
    ds_read_b128 v[76:79], v13 offset:7168
    v_cvt_pk_bf16_f32 v54, v30, v34
    v_mfma_f32_16x16x32_bf16 v[24:27], v[204:207], v[80:83], v[24:27]
    v_cvt_pk_bf16_f32 v55, v31, v35
    s_waitcnt lgkmcnt(2)
    v_mfma_f32_16x16x32_bf16 v[20:23], v[208:211], v[68:71], v[20:23]
    ds_read_b128 v[80:83], v13 offset:7680
    buffer_store_dwordx4 v[52:55], v7, s[36:39], s44 offen sc1
    v_mfma_f32_16x16x32_bf16 v[24:27], v[212:215], v[68:71], v[24:27]
    s_lshl_b32 s58, s43, 6
    s_mul_i32 s60, s61, 18432
    s_waitcnt lgkmcnt(2)
    v_mfma_f32_16x16x32_bf16 v[20:23], v[216:219], v[72:75], v[20:23]
    ds_read_b128 v[68:71], v13 offset:8192
    v_add_u32 v16, s58, v15
    v_mfma_f32_16x16x32_bf16 v[24:27], v[220:223], v[72:75], v[24:27]
    ds_read_b32 v57, v16
    s_waitcnt lgkmcnt(3)
    v_mfma_f32_16x16x32_bf16 v[20:23], v[224:227], v[76:79], v[20:23]
    ds_read_b128 v[72:75], v13 offset:8704
    v_add_u32 v14, s60, v12
    v_mfma_f32_16x16x32_bf16 v[24:27], v[228:231], v[76:79], v[24:27]
    s_waitcnt lgkmcnt(3)
    v_mfma_f32_16x16x32_bf16 v[20:23], v[232:235], v[80:83], v[20:23]
    ds_read_b128 v[76:79], v14 offset:0
    v_mfma_f32_16x16x32_bf16 v[24:27], v[236:239], v[80:83], v[24:27]
    s_waitcnt lgkmcnt(3)
    v_mfma_f32_16x16x32_bf16 v[20:23], v[240:243], v[68:71], v[20:23]
    ds_read_b128 v[80:83], v14 offset:512
    v_mfma_f32_16x16x32_bf16 v[24:27], v[244:247], v[68:71], v[24:27]
    s_waitcnt lgkmcnt(2)
    v_mfma_f32_16x16x32_bf16 v[20:23], v[248:251], v[72:75], v[20:23]
    ds_read_b128 v[68:71], v14 offset:1024
    v_mfma_f32_16x16x32_bf16 v[24:27], v[252:255], v[72:75], v[24:27]
    s_mov_b32 s49, s43
    s_mov_b32 s44, s45
    s_mov_b32 s43, s61
    s_mul_i32 s45, s43, 147456
    s_add_u32 s45, s45, s65
    s_cmp_lg_u32 s42, 0
    s_cbranch_scc1 L_np0
    v_fma_f32 v92, -v44, v65, v92
    v_fma_f32 v93, -v45, v65, v93
    v_fma_f32 v94, -v46, v65, v94
    v_fma_f32 v95, -v47, v65, v95
    v_fma_f32 v96, -v48, v65, v96
    v_fma_f32 v97, -v49, v65, v97
    v_fma_f32 v98, -v50, v65, v98
    v_fma_f32 v99, -v51, v65, v99
    v_mul_f32 v92, v36, v92
    v_mul_f32 v93, v37, v93
    v_mul_f32 v94, v38, v94
    v_mul_f32 v95, v39, v95
    v_mul_f32 v96, v40, v96
    v_mul_f32 v97, v41, v97
    v_mul_f32 v98, v42, v98
    v_mul_f32 v99, v43, v99
    v_cvt_pk_bf16_f32 v52, v92, v96
    v_cvt_pk_bf16_f32 v53, v93, v97
    v_cvt_pk_bf16_f32 v54, v94, v98
    v_cvt_pk_bf16_f32 v55, v95, v99
    buffer_store_dwordx4 v[52:55], v7, s[36:39], s53 offen sc1
L_np0:
    s_waitcnt lgkmcnt(2)
    v_mfma_f32_16x16x32_bf16 v[28:31], v[112:115], v[76:79], 0
    ds_read_b128 v[72:75], v14 offset:1536
    v_mfma_f32_16x16x32_bf16 v[32:35], v[116:119], v[76:79], 0
    s_add_u32 s61, s43, 1
    s_waitcnt lgkmcnt(2)
    v_mfma_f32_16x16x32_bf16 v[28:31], v[120:123], v[80:83], v[28:31]
    ds_read_b128 v[76:79], v14 offset:2048
    v_mfma_f32_16x16x32_bf16 v[32:35], v[124:127], v[80:83], v[32:35]
    s_and_b32 s61, s61, 7
    s_waitcnt lgkmcnt(2)
    v_mfma_f32_16x16x32_bf16 v[28:31], v[128:131], v[68:71], v[28:31]
    ds_read_b128 v[80:83], v14 offset:2560
    v_fma_f32 v20, -v44, v57, v20
    v_mfma_f32_16x16x32_bf16 v[32:35], v[132:135], v[68:71], v[32:35]
    v_fma_f32 v21, -v45, v57, v21
    s_waitcnt lgkmcnt(2)
    v_mfma_f32_16x16x32_bf16 v[28:31], v[136:139], v[72:75], v[28:31]
    ds_read_b128 v[68:71], v14 offset:3072
    v_fma_f32 v22, -v46, v57, v22
    v_mfma_f32_16x16x32_bf16 v[32:35], v[140:143], v[72:75], v[32:35]
    v_fma_f32 v23, -v47, v57, v23
    s_waitcnt lgkmcnt(2)
    v_mfma_f32_16x16x32_bf16 v[28:31], v[144:147], v[76:79], v[28:31]
    ds_read_b128 v[72:75], v14 offset:3584
    v_fma_f32 v24, -v48, v57, v24
    v_mfma_f32_16x16x32_bf16 v[32:35], v[148:151], v[76:79], v[32:35]
    v_fma_f32 v25, -v49, v57, v25
    s_waitcnt lgkmcnt(2)
    v_mfma_f32_16x16x32_bf16 v[28:31], v[152:155], v[80:83], v[28:31]
    ds_read_b128 v[76:79], v14 offset:4096
    v_fma_f32 v26, -v50, v57, v26
    v_mfma_f32_16x16x32_bf16 v[32:35], v[156:159], v[80:83], v[32:35]
    v_fma_f32 v27, -v51, v57, v27
    s_waitcnt lgkmcnt(2)
    v_mfma_f32_16x16x32_bf16 v[28:31], v[160:163], v[68:71], v[28:31]
    ds_read_b128 v[80:83], v14 offset:4608
    v_mul_f32 v20, v36, v20
    v_mfma_f32_16x16x32_bf16 v[32:35], v[164:167], v[68:71], v[32:35]
    v_mul_f32 v21, v37, v21
    s_waitcnt lgkmcnt(2)
    v_mfma_f32_16x16x32_bf16 v[28:31], v[168:171], v[72:75], v[28:31]
    ds_read_b128 v[68:71], v14 offset:5120
    v_mul_f32 v22, v38, v22
    v_mfma_f32_16x16x32_bf16 v[32:35], v[172:175], v[72:75], v[32:35]
    v_mul_f32 v23, v39, v23
    s_waitcnt lgkmcnt(2)
    v_mfma_f32_16x16x32_bf16 v[28:31], v[176:179], v[76:79], v[28:31]
    ds_read_b128 v[72:75], v14 offset:5632
    v_mul_f32 v24, v40, v24
    v_mfma_f32_16x16x32_bf16 v[32:35], v[180:183], v[76:79], v[32:35]
    v_mul_f32 v25, v41, v25
    s_waitcnt lgkmcnt(2)
    v_mfma_f32_16x16x32_bf16 v[28:31], v[184:187], v[80:83], v[28:31]
    ds_read_b128 v[76:79], v14 offset:6144
    v_mul_f32 v26, v42, v26
    v_mfma_f32_16x16x32_bf16 v[32:35], v[188:191], v[80:83], v[32:35]
    v_mul_f32 v27, v43, v27
    s_waitcnt lgkmcnt(2)
    v_mfma_f32_16x16x32_bf16 v[28:31], v[192:195], v[68:71], v[28:31]
    ds_read_b128 v[80:83], v14 offset:6656
    v_cvt_pk_bf16_f32 v52, v20, v24
    v_mfma_f32_16x16x32_bf16 v[32:35], v[196:199], v[68:71], v[32:35]
    v_cvt_pk_bf16_f32 v53, v21, v25
    s_waitcnt lgkmcnt(2)
    v_mfma_f32_16x16x32_bf16 v[28:31], v[200:203], v[72:75], v[28:31]
    ds_read_b128 v[68:71], v14 offset:7168
    v_cvt_pk_bf16_f32 v54, v22, v26
    v_mfma_f32_16x16x32_bf16 v[32:35], v[204:207], v[72:75], v[32:35]
    v_cvt_pk_bf16_f32 v55, v23, v27
    s_waitcnt lgkmcnt(2)
    v_mfma_f32_16x16x32_bf16 v[28:31], v[208:211], v[76:79], v[28:31]
    ds_read_b128 v[72:75], v14 offset:7680
    buffer_store_dwordx4 v[52:55], v7, s[36:39], s44 offen sc1
    v_mfma_f32_16x16x32_bf16 v[32:35], v[212:215], v[76:79], v[32:35]
    s_lshl_b32 s58, s43, 6
    s_mul_i32 s60, s61, 18432
    s_waitcnt lgkmcnt(2)
    v_mfma_f32_16x16x32_bf16 v[28:31], v[216:219], v[80:83], v[28:31]
    ds_read_b128 v[76:79], v14 offset:8192
    v_add_u32 v16, s58, v15
    v_mfma_f32_16x16x32_bf16 v[32:35], v[220:223], v[80:83], v[32:35]
    ds_read_b32 v56, v16
    s_waitcnt lgkmcnt(3)
    v_mfma_f32_16x16x32_bf16 v[28:31], v[224:227], v[68:71], v[28:31]
    ds_read_b128 v[80:83], v14 offset:8704
    v_add_u32 v13, s60, v12
    v_mfma_f32_16x16x32_bf16 v[32:35], v[228:231], v[68:71], v[32:35]
    s_waitcnt lgkmcnt(3)
    v_mfma_f32_16x16x32_bf16 v[28:31], v[232:235], v[72:75], v[28:31]
    ds_read_b128 v[68:71], v13 offset:0
    v_mfma_f32_16x16x32_bf16 v[32:35], v[236:239], v[72:75], v[32:35]
    s_waitcnt lgkmcnt(3)
    v_mfma_f32_16x16x32_bf16 v[28:31], v[240:243], v[76:79], v[28:31]
    ds_read_b128 v[72:75], v13 offset:512
    v_mfma_f32_16x16x32_bf16 v[32:35], v[244:247], v[76:79], v[32:35]
    s_waitcnt lgkmcnt(2)
    v_mfma_f32_16x16x32_bf16 v[28:31], v[248:251], v[80:83], v[28:31]
    ds_read_b128 v[76:79], v13 offset:1024
    v_mfma_f32_16x16x32_bf16 v[32:35], v[252:255], v[80:83], v[32:35]
    s_mov_b32 s49, s43
    s_mov_b32 s44, s45
    s_mov_b32 s43, s61
    s_mul_i32 s45, s43, 147456
    s_add_u32 s45, s45, s65
    s_cmp_lg_u32 s42, 0
    s_cbranch_scc1 L_np1
    v_fma_f32 v100, -v44, v66, v100
    v_fma_f32 v101, -v45, v66, v101
    v_fma_f32 v102, -v46, v66, v102
    v_fma_f32 v103, -v47, v66, v103
    v_fma_f32 v104, -v48, v66, v104
    v_fma_f32 v105, -v49, v66, v105
    v_fma_f32 v106, -v50, v66, v106
    v_fma_f32 v107, -v51, v66, v107
    v_mul_f32 v100, v36, v100
    v_mul_f32 v101, v37, v101
    v_mul_f32 v102, v38, v102
    v_mul_f32 v103, v39, v103
    v_mul_f32 v104, v40, v104
    v_mul_f32 v105, v41, v105
    v_mul_f32 v106, v42, v106
    v_mul_f32 v107, v43, v107
    v_cvt_pk_bf16_f32 v52, v100, v104
    v_cvt_pk_bf16_f32 v53, v101, v105
    v_cvt_pk_bf16_f32 v54, v102, v106
    v_cvt_pk_bf16_f32 v55, v103, v107
    buffer_store_dwordx4 v[52:55], v7, s[36:39], s54 offen sc1
L_np1:
    s_add_u32 s42, s42, 1
    s_lshl_b32 s58, s3, 6
    s_and_b32 s58, s58, 0x100
    s_add_u32 s58, s58, s42
    s_cmp_eq_u32 s58, 1
    s_cbranch_scc1 L_n8job
    s_cmp_lt_u32 s42, 2
    s_cbranch_scc1 L_trip
L_seg0:
    v_fma_f32 v28, -v44, v56, v28
    v_fma_f32 v29, -v45, v56, v29
    v_fma_f32 v30, -v46, v56, v30
    v_fma_f32 v31, -v47, v56, v31
    v_fma_f32 v32, -v48, v56, v32
    v_fma_f32 v33, -v49, v56, v33
    v_fma_f32 v34, -v50, v56, v34
    v_fma_f32 v35, -v51, v56, v35
    v_mul_f32 v28, v36, v28
    v_mul_f32 v29, v37, v29
    v_mul_f32 v30, v38, v30
    v_mul_f32 v31, v39, v31
    v_mul_f32 v32, v40, v32
    v_mul_f32 v33, v41, v33
    v_mul_f32 v34, v42, v34
    v_mul_f32 v35, v43, v35
    v_cvt_pk_bf16_f32 v52, v28, v32
    v_cvt_pk_bf16_f32 v53, v29, v33
    v_cvt_pk_bf16_f32 v54, v30, v34
    v_cvt_pk_bf16_f32 v55, v31, v35
    s_cbranch_execz L_sk0
    buffer_store_dwordx4 v[52:55], v7, s[36:39], s44 offen sc1
L_sk0:
    s_cbranch_execz L_sk1
    s_branch L_end
L_sk1:
L_n8job:
    s_mul_i32 s58, s14, 36864
    v_add_u32 v16, s58, v12
    v_lshlrev_b32 v17, 3, v0
    v_add_u32 v17, 147968, v17
    ds_read_b64 v[108:109], v17
    ds_read_b128 v[60:63], v16
    ds_read_b64 v[110:111], v17 offset:512
    ds_read_b128 v[64:67], v16 offset:18432
    s_lshl_b32 s58, s14, 7
    v_add_u32 v18, s58, v15
    s_waitcnt lgkmcnt(3)
    v_mov_b32 v68, 0
    v_mov_b32 v69, 0
    v_mov_b32 v70, 0
    v_mov_b32 v71, 0
    v_mov_b32 v72, 0
    v_mov_b32 v73, 0
    v_mov_b32 v74, 0
    v_mov_b32 v75, 0
    v_mov_b32 v76, 0
    v_mov_b32 v77, 0
    v_mov_b32 v78, 0
    v_mov_b32 v79, 0
    v_mov_b32 v80, 0
    v_mov_b32 v81, 0
    v_mov_b32 v82, 0
    v_mov_b32 v83, 0
    s_cbranch_execz L_wret
L_seg1:
    v_pk_lshrrev_b16 v92, v9, v108 op_sel:[0,0] op_sel_hi:[1,0]
    v_pk_lshrrev_b16 v93, v10, v108 op_sel:[0,0] op_sel_hi:[1,0]
    v_pk_lshrrev_b16 v94, v9, v108 op_sel:[0,1] op_sel_hi:[1,1]
    v_pk_lshrrev_b16 v95, v10, v108 op_sel:[0,1] op_sel_hi:[1,1]
    v_and_or_b32 v92, v92, s64, v8
    v_and_or_b32 v93, v93, s64, v8
    v_and_or_b32 v94, v94, s64, v8
    v_and_or_b32 v95, v95, s64, v8
    v_pk_lshrrev_b16 v96, v9, v109 op_sel:[0,0] op_sel_hi:[1,0]
    v_pk_lshrrev_b16 v97, v10, v109 op_sel:[0,0] op_sel_hi:[1,0]
    v_pk_lshrrev_b16 v98, v9, v109 op_sel:[0,1] op_sel_hi:[1,1]
    v_pk_lshrrev_b16 v99, v10, v109 op_sel:[0,1] op_sel_hi:[1,1]
    v_and_or_b32 v96, v96, s64, v8
    v_and_or_b32 v97, v97, s64, v8
    v_and_or_b32 v98, v98, s64, v8
    v_and_or_b32 v99, v99, s64, v8
    s_mov_b32 s48, 0
L_n8:
    s_waitcnt lgkmcnt(1)
    v_mfma_f32_16x16x32_bf16 v[68:71], v[92:95], v[60:63], v[68:71]
    ds_read_b128 v[84:87], v16 offset:512
    v_pk_lshrrev_b16 v100, v9, v110 op_sel:[0,0] op_sel_hi:[1,0]
    v_pk_lshrrev_b16 v101, v10, v110 op_sel:[0,0] op_sel_hi:[1,0]
    v_pk_lshrrev_b16 v102, v9, v110 op_sel:[0,1] op_sel_hi:[1,1]
    v_pk_lshrrev_b16 v103, v10, v110 op_sel:[0,1] op_sel_hi:[1,1]
    v_mfma_f32_16x16x32_bf16 v[72:75], v[96:99], v[60:63], v[72:75]
    ds_read_b64 v[108:109], v17 offset:1024
    v_and_or_b32 v100, v100, s64, v8
    v_and_or_b32 v101, v101, s64, v8
    v_and_or_b32 v102, v102, s64, v8
    v_and_or_b32 v103, v103, s64, v8
    s_waitcnt lgkmcnt(2)
    v_mfma_f32_16x16x32_bf16 v[76:79], v[92:95], v[64:67], v[76:79]
    ds_read_b128 v[88:91], v16 offset:18944
    v_pk_lshrrev_b16 v104, v9, v111 op_sel:[0,0] op_sel_hi:[1,0]
    v_pk_lshrrev_b16 v105, v10, v111 op_sel:[0,0] op_sel_hi:[1,0]
    v_pk_lshrrev_b16 v106, v9, v111 op_sel:[0,1] op_sel_hi:[1,1]
    v_pk_lshrrev_b16 v107, v10, v111 op_sel:[0,1] op_sel_hi:[1,1]
    v_mfma_f32_16x16x32_bf16 v[80:83], v[96:99], v[64:67], v[80:83]
    v_and_or_b32 v104, v104, s64, v8
    v_and_or_b32 v105, v105, s64, v8
    v_and_or_b32 v106, v106, s64, v8
    v_and_or_b32 v107, v107, s64, v8
    s_add_u32 s48, s48, 1
    s_waitcnt lgkmcnt(1)
    v_mfma_f32_16x16x32_bf16 v[68:71], v[100:103], v[84:87], v[68:71]
    ds_read_b128 v[60:63], v16 offset:1024
    v_pk_lshrrev_b16 v92, v9, v108 op_sel:[0,0] op_sel_hi:[1,0]
    v_pk_lshrrev_b16 v93, v10, v108 op_sel:[0,0] op_sel_hi:[1,0]
    v_pk_lshrrev_b16 v94, v9, v108 op_sel:[0,1] op_sel_hi:[1,1]
    v_pk_lshrrev_b16 v95, v10, v108 op_sel:[0,1] op_sel_hi:[1,1]
    v_mfma_f32_16x16x32_bf16 v[72:75], v[104:107], v[84:87], v[72:75]
    ds_read_b64 v[110:111], v17 offset:1536
    v_and_or_b32 v92, v92, s64, v8
    v_and_or_b32 v93, v93, s64, v8
    v_and_or_b32 v94, v94, s64, v8
    v_and_or_b32 v95, v95, s64, v8
    s_waitcnt lgkmcnt(2)
    v_mfma_f32_16x16x32_bf16 v[76:79], v[100:103], v[88:91], v[76:79]
    ds_read_b128 v[64:67], v16 offset:19456
    v_pk_lshrrev_b16 v96, v9, v109 op_sel:[0,0] op_sel_hi:[1,0]
    v_pk_lshrrev_b16 v97, v10, v109 op_sel:[0,0] op_sel_hi:[1,0]
    v_pk_lshrrev_b16 v98, v9, v109 op_sel:[0,1] op_sel_hi:[1,1]
    v_pk_lshrrev_b16 v99, v10, v109 op_sel:[0,1] op_sel_hi:[1,1]
    v_mfma_f32_16x16x32_bf16 v[80:83], v[104:107], v[88:91], v[80:83]
    v_and_or_b32 v96, v96, s64, v8
    v_and_or_b32 v97, v97, s64, v8
    v_and_or_b32 v98, v98, s64, v8
    v_and_or_b32 v99, v99, s64, v8
    v_add_u32 v16, 1024, v16
    v_add_u32 v17, 1024, v17
    s_cmp_lt_u32 s48, 9
    s_cbranch_execz L_sk2
    s_cbranch_scc1 L_n8
L_sk2:
    s_cbranch_execz L_wret
L_seg2:
    v_lshlrev_b32 v17, 4, v3
    v_add_u32 v17, 157696, v17
    ds_read_b128 v[84:87], v17
    ds_read_b128 v[88:91], v17 offset:1024
    ds_read_b32 v58, v18
    ds_read_b32 v59, v18 offset:64
    s_waitcnt lgkmcnt(2)
    v_lshlrev_b32 v92, 16, v84
    v_and_b32 v96, 0xffff0000, v84
    v_lshlrev_b32 v100, 16, v88
    v_and_b32 v104, 0xffff0000, v88
    v_add_f32 v100, v11, v100
    v_add_f32 v104, v11, v104
    v_lshlrev_b32 v93, 16, v85
    v_and_b32 v97, 0xffff0000, v85
    v_lshlrev_b32 v101, 16, v89
    v_and_b32 v105, 0xffff0000, v89
    v_add_f32 v101, v11, v101
    v_add_f32 v105, v11, v105
    v_lshlrev_b32 v94, 16, v86
    v_and_b32 v98, 0xffff0000, v86
    v_lshlrev_b32 v102, 16, v90
    v_and_b32 v106, 0xffff0000, v90
    v_add_f32 v102, v11, v102
    v_add_f32 v106, v11, v106
    v_lshlrev_b32 v95, 16, v87
    v_and_b32 v99, 0xffff0000, v87
    v_lshlrev_b32 v103, 16, v91
    v_and_b32 v107, 0xffff0000, v91
    v_add_f32 v103, v11, v103
    v_add_f32 v107, v11, v107
    s_waitcnt lgkmcnt(0)
    s_cbranch_execz L_wret
L_seg3:
    v_fma_f32 v68, -v100, v58, v68
    v_fma_f32 v69, -v101, v58, v69
    v_fma_f32 v70, -v102, v58, v70
    v_fma_f32 v71, -v103, v58, v71
    v_fma_f32 v72, -v104, v58, v72
    v_fma_f32 v73, -v105, v58, v73
    v_fma_f32 v74, -v106, v58, v74
    v_fma_f32 v75, -v107, v58, v75
    v_mul_f32 v68, v92, v68
    v_mul_f32 v69, v93, v69
    v_mul_f32 v70, v94, v70
    v_mul_f32 v71, v95, v71
    v_mul_f32 v72, v96, v72
    v_mul_f32 v73, v97, v73
    v_mul_f32 v74, v98, v74
    v_mul_f32 v75, v99, v75
    v_cvt_pk_bf16_f32 v52, v68, v72
    v_cvt_pk_bf16_f32 v53, v69, v73
    v_cvt_pk_bf16_f32 v54, v70, v74
    v_cvt_pk_bf16_f32 v55, v71, v75
    s_cbranch_execz L_sk3
    buffer_store_dwordx4 v[52:55], v7, s[36:39], s50 offen sc1
L_sk3:
    v_fma_f32 v76, -v100, v59, v76
    v_fma_f32 v77, -v101, v59, v77
    v_fma_f32 v78, -v102, v59, v78
    v_fma_f32 v79, -v103, v59, v79
    v_fma_f32 v80, -v104, v59, v80
    v_fma_f32 v81, -v105, v59, v81
    v_fma_f32 v82, -v106, v59, v82
    v_fma_f32 v83, -v107, v59, v83
    v_mul_f32 v76, v92, v76
    v_mul_f32 v77, v93, v77
    v_mul_f32 v78, v94, v78
    v_mul_f32 v79, v95, v79
    v_mul_f32 v80, v96, v80
    v_mul_f32 v81, v97, v81
    v_mul_f32 v82, v98, v82
    v_mul_f32 v83, v99, v83
    v_cvt_pk_bf16_f32 v52, v76, v80
    v_cvt_pk_bf16_f32 v53, v77, v81
    v_cvt_pk_bf16_f32 v54, v78, v82
    v_cvt_pk_bf16_f32 v55, v79, v83
    s_cbranch_execz L_sk4
    buffer_store_dwordx4 v[52:55], v7, s[36:39], s51 offen sc1
L_sk4:
    s_cbranch_execz L_sk5
    s_branch L_pref
L_sk5:
    s_cbranch_execz L_wret
L_end:
L_done:
    s_endpgm
.section .rodata,"a"
.p2align 6
.amdhsa_kernel standalone__weight_only_int_gptq__prompt_kernel
  .amdhsa_next_free_vgpr 256
  .amdhsa_next_free_sgpr 102
  .amdhsa_accum_offset 256
  .amdhsa_group_segment_fixed_size 0
  .amdhsa_kernarg_size 64
  .amdhsa_user_sgpr_count 2
  .amdhsa_user_sgpr_kernarg_segment_ptr 1
  .amdhsa_system_sgpr_workgroup_id_x 1
  .amdhsa_float_denorm_mode_32 3
.end_amdhsa_kernel
```
